```python
import torch

def _softmax(x, axis=-1):
    return torch.softmax(x, dim=axis)
def _gelu(x):
    return torch.nn.functional.gelu(x, approximate="tanh")
def _silu(x):
    return torch.nn.functional.silu(x)
def _sigmoid(x):
    return torch.sigmoid(x)
def _layernorm(x, axis=-1, eps=1e-5):
    m = x.mean(dim=axis, keepdim=True)
    v = x.var(dim=axis, keepdim=True, unbiased=False)
    return (x - m) / torch.sqrt(v + eps)
def _scatter_add(tgt, idx, src, axis=0):
    return tgt.clone().index_add_(axis, idx, src)
def _segment_sum(src, seg, n):
    out = torch.zeros((n,) + src.shape[1:], dtype=src.dtype)
    return out.index_add_(0, seg, src)
def _pad(x, pw):
    flat = tuple(v for pair in reversed(pw) for v in pair)
    return torch.nn.functional.pad(x, flat)

kernel_name = 'standalone__detection_seg_dino__vision'

def setup_inputs():

    _w = (lambda a: (lambda t: t.to(torch.bfloat16) if t.is_floating_point() else t)(torch.as_tensor(a)))
    H = W = (384 // 2) * 2
    C = 96
    Nq = 16
    sc = C ** -0.5
    return {
        "q": _w((lambda *s: torch.randn(*s, dtype=torch.bfloat16) * 0.05)(1, Nq, C)),
        "f0": _w((lambda *s: torch.randn(*s, dtype=torch.bfloat16) * 0.8)(1, H, W, C)),
        "f1": _w((lambda *s: torch.randn(*s, dtype=torch.bfloat16) * 0.8)(1, H // 2, W // 2, C)),
        "wq": _w((lambda *s: torch.randn(*s, dtype=torch.bfloat16) * 3.2)(C, C) * sc),
        "wk": _w((lambda *s: torch.randn(*s, dtype=torch.bfloat16) * 3.2)(C, C) * sc),
        "wv": _w((lambda *s: torch.randn(*s, dtype=torch.bfloat16) * 0.8)(C, C) * sc),
        "wo": _w((lambda *s: torch.randn(*s, dtype=torch.bfloat16) * 0.8)(C, C) * sc),
    }

def reference(q, f0, f1, wq, wk, wv, wo):
    B, H, W, C = f0.shape
    f1u = (lambda x, n, axis: torch.repeat_interleave(x, n, dim=axis))((lambda x, n, axis: torch.repeat_interleave(x, n, dim=axis))(f1, 2, axis=1), 2, axis=2)
    fused = f0 + f1u
    feats = _layernorm(fused.reshape(B, H * W, C), axis=-1)
    qn = _layernorm(q, axis=-1)
    Q = torch.einsum("bnc,cd->bnd", qn, wq)
    K = torch.einsum("bmc,cd->bmd", feats, wk)
    V = torch.einsum("bmc,cd->bmd", feats, wv)
    scale = C ** -0.5
    logits = torch.einsum("bnd,bmd->bnm", Q, K) * scale
    attn = _softmax(logits, axis=-1)
    ctx = torch.einsum("bnm,bmd->bnd", attn, V)
    return q + torch.einsum("bnd,dc->bnc", ctx, wo)
```

```asm
; @launch grid=(256,1,1) block=(576,1,1) lds=163840
.amdgcn_target "amdgcn-amd-amdhsa--gfx950"
.text
.p2align 12
.skip 3328
.globl standalone__detection_seg_dino__vision_kernel
.p2align 8
.type standalone__detection_seg_dino__vision_kernel,@function
standalone__detection_seg_dino__vision_kernel:
  s_load_dwordx16 s[4:19], s[0:1], 0
  s_load_dwordx4 s[20:23], s[0:1], 64
  s_cmp_ge_u32 s2, 256
  s_cbranch_scc1 L_exit
  v_lshrrev_b32 v3, 6, v0
  v_mov_b32 v4, 159744
  v_and_b32 v0, 63, v0
  v_readfirstlane_b32 s3, v3
  s_mov_b32 s33, 1048576
  v_lshlrev_b32 v1, 4, v0
  s_cmp_lg_u32 s3, 0
  s_cbranch_scc1 L_worker
  s_setprio 3
  v_mov_b32 v5, 0
  v_lshl_add_u32 v6, v0, 2, v4
  ds_write_b32 v6, v5
  v_cmp_le_u32 vcc, 48, v0
  s_nop 1
  v_cndmask_b32 v6, 0, 32, vcc
  v_cmp_gt_u32 vcc, 16, v0
  s_nop 1
  v_cndmask_b32 v8, 16, 48, vcc
  v_cmp_gt_u32 vcc, 32, v0
  s_nop 1
  v_cndmask_b32 v7, 48, 32, vcc
  v_cndmask_b32 v11, 32, 0, vcc
  v_cndmask_b32 v14, 16, 48, vcc
  v_xor_b32 v6, v6, v1
  v_xor_b32 v7, v7, v1
  v_xor_b32 v8, v8, v1
  v_mov_b32 v10, v1
  v_xor_b32 v11, v11, v10
  v_xor_b32 v12, 32, v10
  v_xor_b32 v13, 48, v10
  v_xor_b32 v14, v14, v10
  v_xor_b32 v15, 16, v10
  s_and_b32 s34, s2, 7
  s_mul_i32 s34, s34, 288
  s_lshr_b32 s35, s2, 3
  s_add_u32 s34, s34, s35
  s_mov_b32 s42, 28311552
  s_mov_b32 s43, 0x20000
  s_mov_b32 s46, 7077888
  s_mov_b32 s47, 0x20000
  v_mov_b32 v9, -6
  s_mov_b32 s32, 0
  s_mov_b32 s48, 1
  s_mov_b32 m0, 107520
  s_waitcnt lgkmcnt(0)
  global_load_lds_dwordx4 v1, s[4:5] offset:0
  global_load_lds_dwordx4 v1, s[4:5] offset:1024
  global_load_lds_dwordx4 v1, s[4:5] offset:2048
  s_mov_b64 s[40:41], s[6:7]
  s_mov_b64 s[44:45], s[8:9]
L_ld_round:
  s_mov_b32 s49, s32
L_ld_a:
  s_lshl_b32 s50, s49, 5
  s_add_u32 s50, s50, s34
  s_mul_hi_u32 s35, s50, 0x15555556
  s_mul_i32 s36, s50, 3072
  s_mul_i32 s37, s35, 73728
  s_lshl_b32 s38, s36, 1
  s_add_u32 s37, s37, s38
  s_and_b32 s39, s49, 7
  s_mul_i32 s39, s39, 15360
  s_cmp_lt_u32 s49, 7
  s_cbranch_scc1 L_ld_go
  s_cmp_eq_u32 s49, 7
  s_cselect_b32 s51, 4, 2
  s_cselect_b32 s38, 4, 0
  v_add_u32 v16, s38, v4
L_poll_1:
  ds_read_b32 v5, v16 offset:16
  s_sub_u32 s33, s33, 1
  s_cbranch_scc1 L_exit
  s_waitcnt lgkmcnt(0)
  v_readfirstlane_b32 s31, v5
  s_nop 0
  s_cmp_ge_i32 s31, s51
  s_cbranch_scc1 L_done_2
  s_sleep 1
  s_branch L_poll_1
L_done_2:
L_ld_go:
  s_mov_b32 m0, s39
  v_add_u32 v9, 1, v9
  buffer_load_dwordx4 v6, s[44:47], s36 offen offset:0 nt lds
  buffer_load_dwordx4 v7, s[44:47], s36 offen offset:1024 nt lds
  buffer_load_dwordx4 v8, s[44:47], s36 offen offset:2048 nt lds
  s_waitcnt vmcnt(21)
  ds_write_b32 v4, v9 offset:0
  s_add_u32 m0, s39, 3072
  v_add_u32 v9, 1, v9
  buffer_load_dwordx4 v10, s[40:43], s37 offen offset:0 nt lds
  buffer_load_dwordx4 v11, s[40:43], s37 offen offset:1024 nt lds
  buffer_load_dwordx4 v12, s[40:43], s37 offen offset:2048 nt lds
  s_waitcnt vmcnt(21)
  ds_write_b32 v4, v9 offset:0
  s_add_u32 m0, s39, 6144
  s_add_u32 s38, s37, 3072
  v_add_u32 v9, 1, v9
  buffer_load_dwordx4 v13, s[40:43], s38 offen offset:0 nt lds
  buffer_load_dwordx4 v14, s[40:43], s38 offen offset:1024 nt lds
  buffer_load_dwordx4 v15, s[40:43], s38 offen offset:2048 nt lds
  s_waitcnt vmcnt(21)
  ds_write_b32 v4, v9 offset:0
  s_add_u32 s49, s49, 1
  s_cmp_lt_u32 s49, s48
  s_cbranch_scc1 L_ld_a
  s_mov_b32 s49, s32
  s_cmp_lg_u32 s32, 0
  s_cbranch_scc1 L_ld_b
  s_barrier
L_ld_b:
  s_lshl_b32 s50, s49, 5
  s_add_u32 s50, s50, s34
  s_mul_hi_u32 s35, s50, 0x15555556
  s_mul_i32 s36, s50, 3072
  s_mul_i32 s37, s35, 73728
  s_lshl_b32 s38, s36, 1
  s_add_u32 s37, s37, s38
  s_and_b32 s39, s49, 7
  s_mul_i32 s39, s39, 15360
  s_add_u32 m0, s39, 9216
  s_add_u32 s38, s37, 73728
  v_add_u32 v9, 1, v9
  buffer_load_dwordx4 v10, s[40:43], s38 offen offset:0 nt lds
  buffer_load_dwordx4 v11, s[40:43], s38 offen offset:1024 nt lds
  buffer_load_dwordx4 v12, s[40:43], s38 offen offset:2048 nt lds
  s_waitcnt vmcnt(21)
  ds_write_b32 v4, v9 offset:0
  s_add_u32 m0, s39, 12288
  s_add_u32 s38, s37, 76800
  v_add_u32 v9, 1, v9
  buffer_load_dwordx4 v13, s[40:43], s38 offen offset:0 nt lds
  buffer_load_dwordx4 v14, s[40:43], s38 offen offset:1024 nt lds
  buffer_load_dwordx4 v15, s[40:43], s38 offen offset:2048 nt lds
  s_waitcnt vmcnt(21)
  ds_write_b32 v4, v9 offset:0
  s_add_u32 s49, s49, 1
  s_cmp_lt_u32 s49, s48
  s_cbranch_scc1 L_ld_b
  s_mov_b32 s32, s48
  s_add_u32 s48, s48, 4
  s_cmp_lt_u32 s32, 9
  s_cbranch_scc1 L_ld_round
L_ld_drain:
  v_add_u32 v9, 1, v9
  s_waitcnt vmcnt(18)
  ds_write_b32 v4, v9 offset:0
  v_add_u32 v9, 1, v9
  s_waitcnt vmcnt(15)
  ds_write_b32 v4, v9 offset:0
  v_add_u32 v9, 1, v9
  s_waitcnt vmcnt(12)
  ds_write_b32 v4, v9 offset:0
  v_add_u32 v9, 1, v9
  s_waitcnt vmcnt(9)
  ds_write_b32 v4, v9 offset:0
  v_add_u32 v9, 1, v9
  s_waitcnt vmcnt(6)
  ds_write_b32 v4, v9 offset:0
  v_add_u32 v9, 1, v9
  s_waitcnt vmcnt(3)
  ds_write_b32 v4, v9 offset:0
  v_add_u32 v9, 1, v9
  s_waitcnt vmcnt(0)
  ds_write_b32 v4, v9 offset:0
  s_endpgm
L_worker:
  s_sub_u32 s26, s3, 1
  s_and_b32 s27, s26, 3
  s_cmp_lt_u32 s3, 4
  s_cbranch_scc1 L_w1
L_w3:
  s_waitcnt lgkmcnt(0)
  s_branch L_q2
L_w1:
  s_mul_i32 s38, s27, 6144
  v_add_u32 v3, s38, v1
  s_add_u32 m0, s38, 124928
  v_add_u32 v3, 2048, v3
  s_setprio 2
  s_waitcnt lgkmcnt(0)
  global_load_lds_dwordx4 v3, s[10:11] offset:-2048
  global_load_lds_dwordx4 v3, s[10:11] offset:-1024
  global_load_lds_dwordx4 v3, s[10:11] offset:0
  global_load_lds_dwordx4 v3, s[10:11] offset:1024
  global_load_lds_dwordx4 v3, s[10:11] offset:2048
  global_load_lds_dwordx4 v3, s[10:11] offset:3072
  s_add_u32 m0, s38, 143360
  s_nop 0
  global_load_lds_dwordx4 v3, s[12:13] offset:-2048
  global_load_lds_dwordx4 v3, s[12:13] offset:-1024
  global_load_lds_dwordx4 v3, s[12:13] offset:0
  global_load_lds_dwordx4 v3, s[12:13] offset:1024
  global_load_lds_dwordx4 v3, s[12:13] offset:2048
  global_load_lds_dwordx4 v3, s[12:13] offset:3072
L_q2:
  v_and_b32 v10, 15, v0
  v_lshrrev_b32 v11, 4, v0
  v_bfe_u32 v12, v0, 2, 2
  v_and_b32 v13, 3, v0
  v_mov_b32 v16, 0x3f803f80
  v_mov_b32 v17, 0x3f803f80
  v_mov_b32 v18, 0x3f803f80
  v_mov_b32 v19, 0x3f803f80
  s_mov_b32 s44, 3156912811
  s_mov_b32 s46, 1009429163
  v_mov_b32 v14, 925353388
  s_mov_b32 s30, 0
  v_mov_b32 v9, 1
  s_cmp_lt_u32 s26, 4
  s_cbranch_scc1 L_noaddr
  s_movk_i32 s28, 0x78
  s_add_u32 s34, s27, 1
  s_cmp_lt_u32 s27, 2
  s_cselect_b32 s34, s34, 0
  s_cselect_b32 s35, 0, 1
  s_mul_i32 s36, s34, 15360
  s_cmp_eq_u32 s27, 3
  s_cselect_b32 s37, 6144, 0
  s_add_u32 s37, s37, s36
  s_add_u32 s37, s37, 3072
  s_mul_i32 s48, s27, 3
  s_add_u32 s48, s48, 7
  s_add_u32 s49, s48, 2
  s_lshl_b32 s50, s27, 1
  s_add_u32 s50, s50, 20
  s_mov_b32 s51, 2
  s_sub_u32 s52, s50, 20
  s_mov_b32 s54, 0
  s_mov_b32 s55, -1
  v_lshlrev_b32 v5, 1, v12
  v_bfe_u32 v5, s28, v5, 2
  v_xor_b32 v5, v5, v11
  v_lshlrev_b32 v5, 4, v5
  v_lshlrev_b32 v6, 1, v11
  v_bfe_u32 v6, s28, v6, 2
  v_lshrrev_b32 v7, 1, v13
  v_xor_b32 v6, v6, v7
  v_lshlrev_b32 v6, 4, v6
  v_and_b32 v7, 1, v13
  v_lshl_add_u32 v6, v7, 3, v6
  v_lshl_add_u32 v7, v11, 2, v12
  v_mul_u32_u24 v162, 192, v10
  v_add3_u32 v162, v162, v5, s36
  v_mul_u32_u24 v163, 192, v7
  v_add3_u32 v163, v163, v6, s36
  v_xor_b32 v164, 32, v163
  v_mul_u32_u24 v156, 384, v10
  v_add3_u32 v156, v156, v5, s37
  v_mul_u32_u24 v157, 384, v7
  v_add3_u32 v157, v157, v6, s37
  v_xor_b32 v158, 32, v157
  v_mov_b32 v36, 0
  v_mov_b32 v37, 0
  v_mov_b32 v38, 0
  v_mov_b32 v39, 0
  v_mov_b32 v40, 0
  v_mov_b32 v41, 0
  v_mov_b32 v42, 0
  v_mov_b32 v43, 0
  v_mov_b32 v44, 0
  v_mov_b32 v45, 0
  v_mov_b32 v46, 0
  v_mov_b32 v47, 0
  v_mov_b32 v48, 0
  v_mov_b32 v49, 0
  v_mov_b32 v50, 0
  v_mov_b32 v51, 0
  v_mov_b32 v52, 0
  v_mov_b32 v53, 0
  v_mov_b32 v54, 0
  v_mov_b32 v55, 0
  v_mov_b32 v56, 0
  v_mov_b32 v57, 0
  v_mov_b32 v58, 0
  v_mov_b32 v59, 0
  v_mov_b32 v22, 0
  s_mov_b32 s45, 0xff800000
  s_mov_b32 s43, 0xff800000
  v_lshlrev_b32 v2, 2, v11
  v_sub_u32 v2, v10, v2
  v_mov_b32 v3, 0x3f80
  v_mov_b32 v6, 0x3f800000
  v_cmp_eq_u32 vcc, 0, v2
  s_nop 1
  v_cndmask_b32 v10, 0, v3, vcc
  v_cmp_eq_u32 vcc, 2, v2
  s_nop 1
  v_cndmask_b32 v11, 0, v3, vcc
  v_cmp_eq_u32 vcc, 1, v2
  s_nop 1
  v_cndmask_b32 v10, v10, v6, vcc
  v_cmp_eq_u32 vcc, 3, v2
  s_nop 1
  v_cndmask_b32 v11, v11, v6, vcc
  v_mov_b32 v12, v10
  v_mov_b32 v13, v11
  v_mov_b32 v166, 0
  v_mov_b32 v167, 0
  v_mov_b32 v20, 0
  v_mov_b32 v21, 0
  v_mov_b32 v132, 0
  v_mov_b32 v133, 0
  v_mov_b32 v134, 0
  v_mov_b32 v135, 0
  s_barrier
  s_cmp_ge_u32 s27, 2
  s_cbranch_scc1 L_group
  s_branch L_nextround
L_noaddr:
  s_cmp_lg_u32 s27, 3
  s_cbranch_scc1 L_qq
  s_barrier
  s_branch L_pad7
L_qq:
  v_lshl_add_u32 v6, v11, 3, v12
  v_mul_u32_u24 v6, 192, v6
  v_lshl_add_u32 v6, v13, 4, v6
  s_lshl_b32 s40, s27, 6
  s_add_u32 s40, s40, 122880
  v_add_u32 v6, s40, v6
  s_lshl_b32 s40, s27, 10
  s_add_u32 s40, s40, 107520
  v_add_u32 v7, s40, v1
  v_add_u32 v15, 160000, v1
  v_mul_u32_u24 v2, 192, v10
  v_lshl_add_u32 v2, v11, 4, v2
  v_add_u32 v2, 107520, v2
  v_lshl_add_u32 v8, v12, 3, v13
  v_mul_u32_u24 v8, 192, v8
  v_lshl_add_u32 v8, v11, 4, v8
  s_add_u32 s40, s38, 141312
  v_add_u32 v8, s40, v8
  v_mov_b32 v3, 0
  v_mov_b32 v20, 1.0
  s_mov_b32 s47, 1041680192
  s_barrier
  s_waitcnt vmcnt(6)
  s_mov_b64 exec, 1
  ds_add_u32 v4, v9 offset:4
  s_mov_b64 exec, -1
  s_cmp_ge_i32 s30, 1
  s_cbranch_scc1 L_done_4
L_poll_3:
  ds_read_b32 v5, v4 offset:0
  s_sub_u32 s33, s33, 1
  s_cbranch_scc1 L_exit
  s_waitcnt lgkmcnt(0)
  v_readfirstlane_b32 s30, v5
  s_nop 0
  s_cmp_ge_i32 s30, 1
  s_cbranch_scc0 L_poll_3
L_done_4:
  ds_read_b128 v[84:87], v2 offset:0
  ds_read_b128 v[88:91], v2 offset:64
  ds_read_b128 v[92:95], v2 offset:128
  s_waitcnt lgkmcnt(0)
  v_dot2c_f32_bf16 v3, v84, v84
  v_dot2c_f32_bf16 v3, v85, v85
  v_dot2c_f32_bf16 v3, v86, v86
  v_dot2c_f32_bf16 v3, v87, v87
  v_dot2c_f32_bf16 v3, v88, v88
  v_dot2c_f32_bf16 v3, v89, v89
  v_dot2c_f32_bf16 v3, v90, v90
  v_dot2c_f32_bf16 v3, v91, v91
  v_dot2c_f32_bf16 v3, v92, v92
  v_dot2c_f32_bf16 v3, v93, v93
  v_dot2c_f32_bf16 v3, v94, v94
  v_dot2c_f32_bf16 v3, v95, v95
  s_nop 2
  v_mfma_f32_16x16x4_f32 v[132:135], v20, v3, 0
  v_mfma_f32_16x16x32_bf16 v[124:127], v[16:19], v[84:87], 0
  v_mfma_f32_16x16x32_bf16 v[124:127], v[16:19], v[88:91], v[124:127]
  v_mfma_f32_16x16x32_bf16 v[124:127], v[16:19], v[92:95], v[124:127]
L_poll_5:
  ds_read_b32 v5, v4 offset:4
  s_sub_u32 s33, s33, 1
  s_cbranch_scc1 L_exit
  s_waitcnt lgkmcnt(0)
  v_readfirstlane_b32 s31, v5
  s_nop 0
  s_cmp_ge_i32 s31, 3
  s_cbranch_scc0 L_poll_5
L_done_6:
  ds_read_b64_tr_b16 v[60:61], v6 offset:0
  ds_read_b64_tr_b16 v[62:63], v6 offset:768
  ds_read_b64_tr_b16 v[64:65], v6 offset:6144
  ds_read_b64_tr_b16 v[66:67], v6 offset:6912
  ds_read_b64_tr_b16 v[68:69], v6 offset:12288
  ds_read_b64_tr_b16 v[70:71], v6 offset:13056
  ds_read_b64_tr_b16 v[72:73], v6 offset:8
  ds_read_b64_tr_b16 v[74:75], v6 offset:776
  ds_read_b64_tr_b16 v[76:77], v6 offset:6152
  ds_read_b64_tr_b16 v[78:79], v6 offset:6920
  ds_read_b64_tr_b16 v[80:81], v6 offset:12296
  ds_read_b64_tr_b16 v[82:83], v6 offset:13064
  v_mul_f32 v2, s46, v124
  v_mul_f32 v3, v124, v124
  v_fma_f32 v3, v3, s44, v132
  v_fma_f32 v3, |v3|, s46, v14
  v_rsq_f32 v3, v3
  s_waitcnt lgkmcnt(6)
  v_mfma_f32_16x16x32_bf16 v[36:39], v[60:63], v[84:87], 0
  v_mfma_f32_16x16x32_bf16 v[44:47], v[60:63], v[16:19], 0
  v_mfma_f32_16x16x32_bf16 v[36:39], v[64:67], v[88:91], v[36:39]
  v_mfma_f32_16x16x32_bf16 v[44:47], v[64:67], v[16:19], v[44:47]
  v_mfma_f32_16x16x32_bf16 v[36:39], v[68:71], v[92:95], v[36:39]
  v_mfma_f32_16x16x32_bf16 v[44:47], v[68:71], v[16:19], v[44:47]
  s_waitcnt lgkmcnt(0)
  v_mfma_f32_16x16x32_bf16 v[40:43], v[72:75], v[84:87], 0
  v_mfma_f32_16x16x32_bf16 v[48:51], v[72:75], v[16:19], 0
  v_mfma_f32_16x16x32_bf16 v[40:43], v[76:79], v[88:91], v[40:43]
  v_mfma_f32_16x16x32_bf16 v[48:51], v[76:79], v[16:19], v[48:51]
  v_mfma_f32_16x16x32_bf16 v[40:43], v[80:83], v[92:95], v[40:43]
  v_mfma_f32_16x16x32_bf16 v[48:51], v[80:83], v[16:19], v[48:51]
  s_nop 0
  v_fma_f32 v36, -v2, v44, v36
  v_fma_f32 v37, -v2, v45, v37
  v_fma_f32 v38, -v2, v46, v38
  v_fma_f32 v39, -v2, v47, v39
  v_mul_f32 v36, v3, v36
  v_mul_f32 v37, v3, v37
  v_mul_f32 v38, v3, v38
  v_mul_f32 v39, v3, v39
  v_fma_f32 v40, -v2, v48, v40
  v_fma_f32 v41, -v2, v49, v41
  v_fma_f32 v42, -v2, v50, v42
  v_fma_f32 v43, -v2, v51, v43
  v_mul_f32 v40, v3, v40
  v_mul_f32 v41, v3, v41
  v_mul_f32 v42, v3, v42
  v_mul_f32 v43, v3, v43
  v_cvt_pk_bf16_f32 v124, v36, v37
  v_cvt_pk_bf16_f32 v125, v38, v39
  v_cvt_pk_bf16_f32 v126, v40, v41
  v_cvt_pk_bf16_f32 v127, v42, v43
  ds_write_b128 v7, v[124:127] offset:52480
  s_mov_b64 exec, 1
  ds_add_u32 v4, v9 offset:8
  s_mov_b64 exec, -1
  s_waitcnt vmcnt(0)
  ds_read_b128 v[60:63], v8 offset:0
  ds_read_b128 v[64:67], v8 offset:64
  ds_read_b128 v[68:71], v8 offset:128
  ds_read_b128 v[72:75], v8 offset:768
  ds_read_b128 v[76:79], v8 offset:832
  ds_read_b128 v[80:83], v8 offset:896
L_poll_7:
  ds_read_b32 v5, v4 offset:8
  s_sub_u32 s33, s33, 1
  s_cbranch_scc1 L_exit
  s_waitcnt lgkmcnt(0)
  v_readfirstlane_b32 s31, v5
  s_nop 0
  s_cmp_ge_i32 s31, 3
  s_cbranch_scc0 L_poll_7
L_done_8:
  ds_read_b128 v[84:87], v15 offset:0
  ds_read_b128 v[88:91], v15 offset:1024
  ds_read_b128 v[92:95], v15 offset:2048
  s_waitcnt lgkmcnt(2)
  v_mfma_f32_16x16x32_bf16 v[36:39], v[60:63], v[84:87], 0
  v_mfma_f32_16x16x32_bf16 v[40:43], v[72:75], v[84:87], 0
  s_waitcnt lgkmcnt(1)
  v_mfma_f32_16x16x32_bf16 v[36:39], v[64:67], v[88:91], v[36:39]
  v_mfma_f32_16x16x32_bf16 v[40:43], v[76:79], v[88:91], v[40:43]
  s_waitcnt lgkmcnt(0)
  v_mfma_f32_16x16x32_bf16 v[36:39], v[68:71], v[92:95], v[36:39]
  v_mfma_f32_16x16x32_bf16 v[40:43], v[80:83], v[92:95], v[40:43]
  s_nop 6
  v_mul_f32 v36, s47, v36
  v_mul_f32 v37, s47, v37
  v_mul_f32 v38, s47, v38
  v_mul_f32 v39, s47, v39
  v_mul_f32 v40, s47, v40
  v_mul_f32 v41, s47, v41
  v_mul_f32 v42, s47, v42
  v_mul_f32 v43, s47, v43
  v_cvt_pk_bf16_f32 v124, v36, v37
  v_cvt_pk_bf16_f32 v125, v38, v39
  v_cvt_pk_bf16_f32 v126, v40, v41
  v_cvt_pk_bf16_f32 v127, v42, v43
  ds_write_b128 v7, v[124:127] offset:0
  s_mov_b64 exec, 1
  ds_add_u32 v4, v9 offset:12
  s_mov_b64 exec, -1
  s_setprio 0
  s_branch L_proj
L_nextround:
  s_mov_b32 s51, s48
  s_mov_b32 s52, s49
  s_mov_b32 s53, s50
  s_add_u32 s48, s48, 20
  s_add_u32 s49, s49, 20
  s_add_u32 s50, s50, 20
L_group:
  s_cmp_ge_i32 s30, s51
  s_cbranch_scc1 L_done_10
L_poll_9:
  ds_read_b32 v5, v4 offset:0
  s_sub_u32 s33, s33, 1
  s_cbranch_scc1 L_exit
  s_waitcnt lgkmcnt(0)
  v_readfirstlane_b32 s30, v5
  s_nop 0
  s_cmp_ge_i32 s30, s51
  s_cbranch_scc1 L_done_10
  s_sleep 1
  s_branch L_poll_9
L_done_10:
  ds_read_b128 v[60:63], v162 offset:0
  ds_read_b128 v[64:67], v162 offset:64
  ds_read_b128 v[68:71], v162 offset:128
  s_add_u32 s38, s27, 1
  s_add_u32 s39, s34, 4
  s_cmp_eq_u32 s34, 0
  s_cselect_b32 s34, s38, s39
  s_and_b32 s38, s34, 7
  s_mul_i32 s38, s38, 15360
  s_sub_u32 s41, s38, s36
  s_mov_b32 s36, s38
  s_add_u32 s42, s38, 3072
  v_mov_b32 v15, 0
  v_mov_b32 v136, 0
  v_mov_b32 v137, 0
  v_mov_b32 v138, 0
  v_mov_b32 v139, 0
  v_add_u32 v162, s41, v162
  s_waitcnt lgkmcnt(0)
  v_dot2c_f32_bf16 v15, v60, v60
  v_dot2c_f32_bf16 v15, v61, v61
  v_dot2c_f32_bf16 v15, v62, v62
  v_dot2c_f32_bf16 v15, v63, v63
  v_dot2c_f32_bf16 v15, v64, v64
  v_dot2c_f32_bf16 v15, v65, v65
  v_dot2c_f32_bf16 v15, v66, v66
  v_dot2c_f32_bf16 v15, v67, v67
  v_dot2c_f32_bf16 v15, v68, v68
  v_dot2c_f32_bf16 v15, v69, v69
  v_dot2c_f32_bf16 v15, v70, v70
  v_dot2c_f32_bf16 v15, v71, v71
  v_mfma_f32_16x16x32_bf16 v[112:115], v[16:19], v[60:63], 0
  ds_read_b64_tr_b16 v[144:145], v163 offset:0
  v_mfma_f32_16x16x32_bf16 v[108:111], v[24:27], v[60:63], 0
  ds_read_b64_tr_b16 v[146:147], v164 offset:0
  v_mfma_f32_16x16x32_bf16 v[112:115], v[16:19], v[64:67], v[112:115]
  ds_read_b64_tr_b16 v[148:149], v163 offset:64
  v_mfma_f32_16x16x32_bf16 v[108:111], v[28:31], v[64:67], v[108:111]
  ds_read_b64_tr_b16 v[150:151], v164 offset:64
  v_mfma_f32_16x16x32_bf16 v[112:115], v[16:19], v[68:71], v[112:115]
  ds_read_b64_tr_b16 v[152:153], v163 offset:128
  v_mfma_f32_16x16x32_bf16 v[108:111], v[32:35], v[68:71], v[108:111]
  ds_read_b64_tr_b16 v[154:155], v164 offset:128
  v_add_u32 v163, s41, v163
  v_add_u32 v164, s41, v164
L_row:
  s_sub_u32 s40, s42, s37
  s_cmp_eq_u32 s35, 0
  s_cselect_b32 s40, 6144, s40
  s_mov_b32 s29, s37
  s_add_u32 s37, s37, s40
  v_mov_b32 v2, v15
  v_mov_b32 v3, v15
  v_mov_b32 v6, 0
  v_mov_b32 v7, 0
  s_cmp_ge_i32 s30, s52
  s_cbranch_scc1 L_done_12
L_poll_11:
  ds_read_b32 v5, v4 offset:0
  s_sub_u32 s33, s33, 1
  s_cbranch_scc1 L_exit
  s_waitcnt lgkmcnt(0)
  v_readfirstlane_b32 s30, v5
  s_nop 0
  s_cmp_ge_i32 s30, s52
  s_cbranch_scc0 L_poll_11
L_done_12:
  ds_read_b128 v[84:87], v156 offset:0
  ds_read_b128 v[88:91], v156 offset:64
  ds_read_b128 v[92:95], v156 offset:128
  ds_read_b128 v[96:99], v156 offset:192
  ds_read_b128 v[100:103], v156 offset:256
  ds_read_b128 v[104:107], v156 offset:320
  ds_read_b64_tr_b16 v[72:73], v157 offset:0
  ds_read_b64_tr_b16 v[74:75], v157 offset:192
  ds_read_b64_tr_b16 v[76:77], v158 offset:0
  s_waitcnt lgkmcnt(8)
  v_dot2c_f32_bf16 v2, v84, v84
  v_dot2c_f32_bf16 v6, v84, v60
  v_dot2c_f32_bf16 v2, v85, v85
  v_dot2c_f32_bf16 v6, v85, v61
  v_dot2c_f32_bf16 v2, v86, v86
  v_dot2c_f32_bf16 v6, v86, v62
  v_dot2c_f32_bf16 v2, v87, v87
  v_dot2c_f32_bf16 v6, v87, v63
  s_waitcnt lgkmcnt(6)
  v_dot2c_f32_bf16 v2, v88, v88
  v_dot2c_f32_bf16 v6, v88, v64
  v_dot2c_f32_bf16 v2, v89, v89
  v_dot2c_f32_bf16 v6, v89, v65
  v_dot2c_f32_bf16 v2, v90, v90
  v_dot2c_f32_bf16 v6, v90, v66
  v_dot2c_f32_bf16 v2, v91, v91
  v_dot2c_f32_bf16 v6, v91, v67
  v_dot2c_f32_bf16 v2, v92, v92
  v_dot2c_f32_bf16 v6, v92, v68
  v_dot2c_f32_bf16 v2, v93, v93
  v_dot2c_f32_bf16 v6, v93, v69
  v_dot2c_f32_bf16 v2, v94, v94
  v_dot2c_f32_bf16 v6, v94, v70
  v_dot2c_f32_bf16 v2, v95, v95
  v_dot2c_f32_bf16 v6, v95, v71
  s_waitcnt lgkmcnt(3)
  v_dot2c_f32_bf16 v3, v96, v96
  v_dot2c_f32_bf16 v7, v96, v60
  v_dot2c_f32_bf16 v3, v97, v97
  v_dot2c_f32_bf16 v7, v97, v61
  v_dot2c_f32_bf16 v3, v98, v98
  v_dot2c_f32_bf16 v7, v98, v62
  v_dot2c_f32_bf16 v3, v99, v99
  v_dot2c_f32_bf16 v7, v99, v63
  v_dot2c_f32_bf16 v3, v100, v100
  v_dot2c_f32_bf16 v7, v100, v64
  v_dot2c_f32_bf16 v3, v101, v101
  v_dot2c_f32_bf16 v7, v101, v65
  v_dot2c_f32_bf16 v3, v102, v102
  v_dot2c_f32_bf16 v7, v102, v66
  v_dot2c_f32_bf16 v3, v103, v103
  v_dot2c_f32_bf16 v7, v103, v67
  v_dot2c_f32_bf16 v3, v104, v104
  v_dot2c_f32_bf16 v7, v104, v68
  v_dot2c_f32_bf16 v3, v105, v105
  v_dot2c_f32_bf16 v7, v105, v69
  v_dot2c_f32_bf16 v3, v106, v106
  v_dot2c_f32_bf16 v7, v106, v70
  v_dot2c_f32_bf16 v3, v107, v107
  v_dot2c_f32_bf16 v7, v107, v71
  v_mfma_f32_16x16x32_bf16 v[124:127], v[16:19], v[84:87], v[112:115]
  v_fma_f32 v2, v6, 2.0, v2
  v_add_u32 v156, s40, v156
  v_mfma_f32_16x16x32_bf16 v[124:127], v[16:19], v[88:91], v[124:127]
  v_fma_f32 v3, v7, 2.0, v3
  s_cmp_lg_u32 s43, 0
  v_mfma_f32_16x16x32_bf16 v[124:127], v[16:19], v[92:95], v[124:127]
  v_permlane32_swap_b32 v2, v3
  v_add_f32 v2, v2, v3
  v_mfma_f32_16x16x32_bf16 v[128:131], v[16:19], v[96:99], v[112:115]
  v_mov_b32 v3, v2
  v_mfma_f32_16x16x32_bf16 v[128:131], v[16:19], v[100:103], v[128:131]
  v_mfma_f32_16x16x32_bf16 v[128:131], v[16:19], v[104:107], v[128:131]
  v_permlane16_swap_b32 v2, v3
  v_add_f32 v2, v2, v3
  s_cbranch_scc1 L_first
  v_mfma_f32_16x16x32_bf16 v[116:119], v[24:27], v[84:87], v[108:111]
  ds_read_b64_tr_b16 v[78:79], v158 offset:192
  v_mfma_f32_16x16x32_bf16 v[116:119], v[28:31], v[88:91], v[116:119]
  ds_read_b64_tr_b16 v[80:81], v157 offset:64
  v_mfma_f32_16x16x32_bf16 v[116:119], v[32:35], v[92:95], v[116:119]
  ds_read_b64_tr_b16 v[82:83], v157 offset:256
  v_cndmask_b32 v3, v124, v128, s[54:55]
  v_mfma_f32_16x16x32_bf16 v[120:123], v[24:27], v[96:99], v[108:111]
  v_mul_f32 v3, v3, v3
  v_fma_f32 v2, v3, s44, v2
  v_mfma_f32_16x16x32_bf16 v[120:123], v[28:31], v[100:103], v[120:123]
  v_fma_f32 v2, |v2|, s46, v14
  v_rsq_f32 v2, v2
  v_mfma_f32_16x16x32_bf16 v[120:123], v[32:35], v[104:107], v[120:123]
  v_mov_b32 v3, v2
  v_fmac_f32 v116, v124, v140
  v_fmac_f32 v117, v124, v141
  v_permlane32_swap_b32 v2, v3
  v_fmac_f32 v118, v124, v142
  v_fmac_f32 v119, v124, v143
  ds_read_b64_tr_b16 v[84:85], v158 offset:64
  v_pk_fma_f32 v[116:117], v[116:117], v[2:3], v[166:167] op_sel_hi:[1,0,1] neg_lo:[0,0,1] neg_hi:[0,0,1]
  v_pk_fma_f32 v[118:119], v[118:119], v[2:3], v[20:21] op_sel_hi:[1,0,1] neg_lo:[0,0,1] neg_hi:[0,0,1]
  v_pk_fma_f32 v[120:121], v[128:129], v[140:141], v[120:121]
  v_pk_fma_f32 v[122:123], v[128:129], v[142:143], v[122:123]
  v_pk_fma_f32 v[120:121], v[120:121], v[2:3], v[166:167] op_sel:[0,1,0] op_sel_hi:[1,1,1] neg_lo:[0,0,1] neg_hi:[0,0,1]
  v_pk_fma_f32 v[122:123], v[122:123], v[2:3], v[20:21] op_sel:[0,1,0] op_sel_hi:[1,1,1] neg_lo:[0,0,1] neg_hi:[0,0,1]
  ds_read_b64_tr_b16 v[86:87], v158 offset:256
L_resc_back:
  v_exp_f32 v124, v116
  v_exp_f32 v125, v117
  v_exp_f32 v126, v118
  v_exp_f32 v127, v119
  v_exp_f32 v128, v120
  v_exp_f32 v129, v121
  v_exp_f32 v130, v122
  v_exp_f32 v131, v123
  v_pk_mul_f32 v[96:97], v[124:125], v[2:3] op_sel_hi:[1,0]
  v_pk_mul_f32 v[98:99], v[126:127], v[2:3] op_sel_hi:[1,0]
  v_pk_mul_f32 v[100:101], v[128:129], v[2:3] op_sel:[0,1] op_sel_hi:[1,1]
  v_pk_mul_f32 v[102:103], v[130:131], v[2:3] op_sel:[0,1] op_sel_hi:[1,1]
  v_cvt_pk_bf16_f32 v104, v96, v97
  v_cvt_pk_bf16_f32 v105, v98, v99
  v_cvt_pk_bf16_f32 v106, v100, v101
  v_cvt_pk_bf16_f32 v107, v102, v103
  v_mfma_f32_16x16x16_bf16 v[96:99], v[104:105], v[10:11], 0
  v_max3_f32 v6, v116, v117, v118
  v_max3_f32 v7, v119, v120, v121
  v_mfma_f32_16x16x16_bf16 v[100:103], v[106:107], v[10:11], 0
  v_max3_f32 v6, v122, v123, v6
  v_max_f32 v6, v6, v7
  v_cmp_lt_f32 vcc, s45, v6
  v_cvt_pk_bf16_f32 v124, v124, v125
  s_cmp_lg_u64 vcc, 0
  s_cbranch_scc1 L_rescale
  v_mfma_f32_16x16x32_bf16 v[136:139], v[104:107], v[10:13], v[136:139]
  v_cvt_pk_bf16_f32 v116, v96, v97
  v_cvt_pk_bf16_f32 v117, v98, v99
  v_cvt_pk_bf16_f32 v118, v100, v101
  v_cvt_pk_bf16_f32 v119, v102, v103
  ds_read_b64_tr_b16 v[88:89], v157 offset:128
  s_waitcnt lgkmcnt(1)
  v_mfma_f32_16x16x32_bf16 v[36:39], v[72:75], v[116:119], v[36:39]
  ds_read_b64_tr_b16 v[90:91], v157 offset:320
  v_mfma_f32_16x16x32_bf16 v[40:43], v[76:79], v[116:119], v[40:43]
  ds_read_b64_tr_b16 v[92:93], v158 offset:128
  v_mfma_f32_16x16x32_bf16 v[44:47], v[80:83], v[116:119], v[44:47]
  ds_read_b64_tr_b16 v[94:95], v158 offset:320
  v_mfma_f32_16x16x32_bf16 v[48:51], v[84:87], v[116:119], v[48:51]
  v_cvt_pk_bf16_f32 v125, v126, v127
  v_cvt_pk_bf16_f32 v126, v128, v129
  s_waitcnt lgkmcnt(2)
  v_mfma_f32_16x16x32_bf16 v[52:55], v[88:91], v[116:119], v[52:55]
  v_cvt_pk_bf16_f32 v127, v130, v131
  s_cmp_eq_u32 s35, 0
  s_waitcnt lgkmcnt(0)
  v_mfma_f32_16x16x32_bf16 v[56:59], v[92:95], v[116:119], v[56:59]
  v_cvt_pk_bf16_f32 v120, v136, v137
  v_cvt_pk_bf16_f32 v121, v138, v139
  v_mfma_f32_16x16x32_bf16 v[132:135], v[124:127], v[10:13], v[132:135]
L_nc:
  s_cbranch_scc0 L_lastrow
  v_add_u32 v157, s40, v157
  v_add_u32 v158, s40, v158
  s_mov_b32 s35, 1
  s_mov_b32 s52, s53
  s_branch L_row
.p2align 12
L_lastrow:
  s_cmp_ge_u32 s34, 9
  s_cbranch_scc1 L_cdone
  v_mfma_f32_16x16x16_bf16 v[36:39], v[144:145], v[120:121], v[36:39]
  v_add_u32 v157, s40, v157
  v_add_u32 v158, s40, v158
  v_mfma_f32_16x16x16_bf16 v[40:43], v[146:147], v[120:121], v[40:43]
  v_mfma_f32_16x16x16_bf16 v[44:47], v[148:149], v[120:121], v[44:47]
  v_mfma_f32_16x16x16_bf16 v[48:51], v[150:151], v[120:121], v[48:51]
  v_mfma_f32_16x16x16_bf16 v[52:55], v[152:153], v[120:121], v[52:55]
  v_mfma_f32_16x16x16_bf16 v[56:59], v[154:155], v[120:121], v[56:59]
  s_mov_b32 s35, 0
  s_cmp_ge_u32 s34, 5
  s_cbranch_scc1 L_nextround
  s_mov_b64 exec, 1
  ds_add_u32 v4, v9 offset:16
  s_mov_b64 exec, -1
  s_branch L_nextround
L_first:
  ds_read_b64_tr_b16 v[78:79], v158 offset:192
  ds_read_b64_tr_b16 v[80:81], v157 offset:64
  ds_read_b64_tr_b16 v[82:83], v157 offset:256
  v_add_u32 v6, 107520, v1
  s_nop 3
  v_cndmask_b32 v3, v124, v128, s[54:55]
  v_mul_f32 v3, v3, v3
  v_fma_f32 v2, v3, s44, v2
  v_fma_f32 v2, |v2|, s46, v14
  v_rsq_f32 v2, v2
  s_nop 0
  v_mov_b32 v3, v2
  s_nop 1
  v_permlane32_swap_b32 v2, v3
L_poll_13:
  ds_read_b32 v5, v4 offset:12
  s_sub_u32 s33, s33, 1
  s_cbranch_scc1 L_exit
  s_waitcnt lgkmcnt(0)
  v_readfirstlane_b32 s31, v5
  s_nop 0
  s_cmp_ge_i32 s31, 3
  s_cbranch_scc1 L_done_14
  s_sleep 1
  s_branch L_poll_13
L_done_14:
  s_setprio 2
  ds_read_b128 v[24:27], v6 offset:0
  ds_read_b128 v[28:31], v6 offset:1024
  ds_read_b128 v[32:35], v6 offset:2048
  s_mov_b64 exec, 1
  ds_add_u32 v4, v9 offset:20
  s_mov_b64 exec, -1
  s_waitcnt lgkmcnt(3)
  v_mfma_f32_16x16x32_bf16 v[108:111], v[24:27], v[60:63], 0
  v_mfma_f32_16x16x32_bf16 v[140:143], v[24:27], v[16:19], 0
  v_mfma_f32_16x16x32_bf16 v[116:119], v[24:27], v[84:87], 0
  v_mfma_f32_16x16x32_bf16 v[120:123], v[24:27], v[96:99], 0
  s_waitcnt lgkmcnt(2)
  v_mfma_f32_16x16x32_bf16 v[108:111], v[28:31], v[64:67], v[108:111]
  v_mfma_f32_16x16x32_bf16 v[140:143], v[28:31], v[16:19], v[140:143]
  v_mfma_f32_16x16x32_bf16 v[116:119], v[28:31], v[88:91], v[116:119]
  v_mfma_f32_16x16x32_bf16 v[120:123], v[28:31], v[100:103], v[120:123]
  s_waitcnt lgkmcnt(1)
  v_mfma_f32_16x16x32_bf16 v[108:111], v[32:35], v[68:71], v[108:111]
  v_mfma_f32_16x16x32_bf16 v[140:143], v[32:35], v[16:19], v[140:143]
  v_mfma_f32_16x16x32_bf16 v[116:119], v[32:35], v[92:95], v[116:119]
  v_mfma_f32_16x16x32_bf16 v[120:123], v[32:35], v[104:107], v[120:123]
  ds_read_b64_tr_b16 v[84:85], v158 offset:64
  ds_read_b64_tr_b16 v[86:87], v158 offset:256
  s_nop 3
  v_mul_f32 v140, s44, v140
  v_mul_f32 v141, s44, v141
  v_mul_f32 v142, s44, v142
  v_mul_f32 v143, s44, v143
  v_pk_add_f32 v[116:117], v[116:117], v[108:109]
  v_pk_add_f32 v[118:119], v[118:119], v[110:111]
  v_pk_add_f32 v[120:121], v[120:121], v[108:109]
  v_pk_add_f32 v[122:123], v[122:123], v[110:111]
  v_pk_fma_f32 v[116:117], v[124:125], v[140:141], v[116:117]
  v_pk_fma_f32 v[118:119], v[124:125], v[142:143], v[118:119]
  v_pk_fma_f32 v[120:121], v[128:129], v[140:141], v[120:121]
  v_pk_fma_f32 v[122:123], v[128:129], v[142:143], v[122:123]
  v_pk_mul_f32 v[116:117], v[116:117], v[2:3] op_sel_hi:[1,0]
  v_pk_mul_f32 v[118:119], v[118:119], v[2:3] op_sel_hi:[1,0]
  v_pk_mul_f32 v[120:121], v[120:121], v[2:3] op_sel:[0,1] op_sel_hi:[1,1]
  v_pk_mul_f32 v[122:123], v[122:123], v[2:3] op_sel:[0,1] op_sel_hi:[1,1]
L_rescale:
  v_max3_f32 v124, v116, v120, s43
  v_max3_f32 v125, v117, v121, s43
  v_max3_f32 v126, v118, v122, s43
  v_max3_f32 v127, v119, v123, s43
  s_mov_b32 s43, 0
  s_mov_b32 s45, 1114636288
  v_max_f32_dpp v124, v124, v124 row_ror:8 row_mask:0xf bank_mask:0xf
  v_max_f32_dpp v125, v125, v125 row_ror:8 row_mask:0xf bank_mask:0xf
  v_max_f32_dpp v126, v126, v126 row_ror:8 row_mask:0xf bank_mask:0xf
  v_max_f32_dpp v127, v127, v127 row_ror:8 row_mask:0xf bank_mask:0xf
  v_max_f32_dpp v124, v124, v124 row_ror:4 row_mask:0xf bank_mask:0xf
  v_max_f32_dpp v125, v125, v125 row_ror:4 row_mask:0xf bank_mask:0xf
  v_max_f32_dpp v126, v126, v126 row_ror:4 row_mask:0xf bank_mask:0xf
  v_max_f32_dpp v127, v127, v127 row_ror:4 row_mask:0xf bank_mask:0xf
  v_max_f32_dpp v124, v124, v124 row_ror:2 row_mask:0xf bank_mask:0xf
  v_max_f32_dpp v125, v125, v125 row_ror:2 row_mask:0xf bank_mask:0xf
  v_max_f32_dpp v126, v126, v126 row_ror:2 row_mask:0xf bank_mask:0xf
  v_max_f32_dpp v127, v127, v127 row_ror:2 row_mask:0xf bank_mask:0xf
  v_max_f32_dpp v124, v124, v124 row_ror:1 row_mask:0xf bank_mask:0xf
  v_max_f32_dpp v125, v125, v125 row_ror:1 row_mask:0xf bank_mask:0xf
  v_max_f32_dpp v126, v126, v126 row_ror:1 row_mask:0xf bank_mask:0xf
  v_max_f32_dpp v127, v127, v127 row_ror:1 row_mask:0xf bank_mask:0xf
  v_and_b32 v6, 3, v0
  v_cmp_eq_u32 vcc, 1, v6
  s_nop 1
  v_cndmask_b32 v7, v124, v125, vcc
  v_cmp_eq_u32 vcc, 2, v6
  s_nop 1
  v_cndmask_b32 v7, v7, v126, vcc
  v_cmp_eq_u32 vcc, 3, v6
  s_nop 1
  v_cndmask_b32 v7, v7, v127, vcc
  v_and_b32 v8, 12, v0
  v_lshlrev_b32 v8, 4, v8
  v_lshl_add_u32 v8, v6, 2, v8
  ds_bpermute_b32 v7, v8, v7
  v_pk_add_f32 v[116:117], v[116:117], v[124:125] neg_lo:[0,1] neg_hi:[0,1]
  v_pk_add_f32 v[118:119], v[118:119], v[126:127] neg_lo:[0,1] neg_hi:[0,1]
  v_pk_add_f32 v[120:121], v[120:121], v[124:125] neg_lo:[0,1] neg_hi:[0,1]
  v_pk_add_f32 v[122:123], v[122:123], v[126:127] neg_lo:[0,1] neg_hi:[0,1]
  v_pk_add_f32 v[166:167], v[166:167], v[124:125]
  v_pk_add_f32 v[20:21], v[20:21], v[126:127]
  s_waitcnt lgkmcnt(0)
  v_exp_f32 v6, -v7 clamp
  v_add_f32 v22, v22, v7
  v_pk_mul_f32 v[36:37], v[36:37], v[6:7] op_sel_hi:[1,0]
  v_pk_mul_f32 v[38:39], v[38:39], v[6:7] op_sel_hi:[1,0]
  v_pk_mul_f32 v[40:41], v[40:41], v[6:7] op_sel_hi:[1,0]
  v_pk_mul_f32 v[42:43], v[42:43], v[6:7] op_sel_hi:[1,0]
  v_pk_mul_f32 v[44:45], v[44:45], v[6:7] op_sel_hi:[1,0]
  v_pk_mul_f32 v[46:47], v[46:47], v[6:7] op_sel_hi:[1,0]
  v_pk_mul_f32 v[48:49], v[48:49], v[6:7] op_sel_hi:[1,0]
  v_pk_mul_f32 v[50:51], v[50:51], v[6:7] op_sel_hi:[1,0]
  v_pk_mul_f32 v[52:53], v[52:53], v[6:7] op_sel_hi:[1,0]
  v_pk_mul_f32 v[54:55], v[54:55], v[6:7] op_sel_hi:[1,0]
  v_pk_mul_f32 v[56:57], v[56:57], v[6:7] op_sel_hi:[1,0]
  v_pk_mul_f32 v[58:59], v[58:59], v[6:7] op_sel_hi:[1,0]
  v_pk_mul_f32 v[132:133], v[132:133], v[6:7] op_sel_hi:[1,0]
  v_pk_mul_f32 v[134:135], v[134:135], v[6:7] op_sel_hi:[1,0]
  v_pk_mul_f32 v[136:137], v[136:137], v[6:7] op_sel_hi:[1,0]
  v_pk_mul_f32 v[138:139], v[138:139], v[6:7] op_sel_hi:[1,0]
  s_branch L_resc_back
L_cdone:
  v_mfma_f32_16x16x16_bf16 v[36:39], v[144:145], v[120:121], v[36:39]
  v_add_u32 v7, s29, v1
  v_and_b32 v8, 15, v0
  v_mfma_f32_16x16x16_bf16 v[40:43], v[146:147], v[120:121], v[40:43]
  v_lshl_add_u32 v8, v8, 3, s29
  v_add_f32 v132, v132, v133
  v_mfma_f32_16x16x16_bf16 v[44:47], v[148:149], v[120:121], v[44:47]
  v_add_f32 v23, v134, v135
  v_add_f32 v23, v23, v132
  v_mfma_f32_16x16x16_bf16 v[48:51], v[150:151], v[120:121], v[48:51]
  v_mov_b32 v6, v23
  v_cvt_pk_bf16_f32 v84, v36, v37
  v_mfma_f32_16x16x16_bf16 v[52:55], v[152:153], v[120:121], v[52:55]
  v_permlane32_swap_b32 v23, v6
  v_add_f32 v23, v23, v6
  v_mfma_f32_16x16x16_bf16 v[56:59], v[154:155], v[120:121], v[56:59]
  v_mov_b32 v6, v23
  v_cvt_pk_bf16_f32 v85, v38, v39
  v_cvt_pk_bf16_f32 v86, v40, v41
  v_cvt_pk_bf16_f32 v87, v42, v43
  ds_write_b128 v7, v[84:87]
  v_permlane16_swap_b32 v23, v6
  v_add_f32 v23, v23, v6
  v_cvt_pk_bf16_f32 v88, v44, v45
  v_cvt_pk_bf16_f32 v89, v46, v47
  v_cvt_pk_bf16_f32 v90, v48, v49
  v_cvt_pk_bf16_f32 v91, v50, v51
  ds_write_b128 v7, v[88:91] offset:1024
  ds_write_b64 v8, v[22:23] offset:3072
  v_lshl_add_u32 v6, s27, 2, v4
  v_cvt_pk_bf16_f32 v92, v52, v53
  v_cvt_pk_bf16_f32 v93, v54, v55
  v_cvt_pk_bf16_f32 v94, v56, v57
  v_cvt_pk_bf16_f32 v95, v58, v59
  ds_write_b128 v7, v[92:95] offset:2048
  ds_write_b32 v6, v9 offset:32
L_cfl2:
  s_cmp_lt_u32 s2, 64
  s_cbranch_scc1 L_consume
  s_endpgm
L_consume:
  s_setprio 0
  v_and_b32 v13, 3, v0
  s_cmp_lg_u32 s27, 0
  s_cbranch_scc1 L_cset
  v_lshrrev_b32 v11, 4, v0
  s_mul_i32 s40, s2, 48
  s_add_u32 s41, s40, 32
  v_lshl_add_u32 v25, v13, 3, s40
  v_lshl_add_u32 v25, v11, 2, v25
  v_lshl_add_u32 v5, v13, 2, s41
  v_cmp_le_u32 vcc, 2, v11
  s_nop 1
  v_cndmask_b32 v25, v25, v5, vcc
  global_load_dword v24, v25, s[4:5]
  global_load_dword v26, v25, s[18:19]
L_cset:
  s_lshl_b32 s38, s2, 14
  s_mul_i32 s39, s27, 2048
  s_add_u32 s38, s38, s39
  v_add_u32 v60, s38, v1
  v_lshlrev_b32 v62, 3, v13
  s_lshl_b32 s38, s27, 9
  s_add_u32 s38, s38, 30720
  v_lshl_add_u32 v63, v0, 3, s38
  v_lshlrev_b32 v64, 3, v0
  v_add_u32 v64, 30720, v64
  s_and_b32 s38, s2, 0xfc
  v_add_u32 v65, s38, v4
  s_movk_i32 s36, 255
  s_mov_b32 s37, 0
  s_waitcnt vmcnt(0) lgkmcnt(0)
  s_barrier
  global_load_dwordx4 v[28:31], v60, s[22:23] offset:0 sc1
  global_load_dwordx4 v[32:35], v60, s[22:23] offset:1024 sc1
  ds_read_b32 v165, v4 offset:28
  ds_read_b32 v66, v65 offset:64
  v_lshlrev_b32 v26, 16, v24
  v_and_b32 v27, 0xffff0000, v24
  s_waitcnt lgkmcnt(0)
  s_mov_b32 s38, 0x9E3779B1
  s_mov_b32 s39, 0x2545F500
  v_mul_lo_u32 v61, v165, s38
  v_mul_lo_u32 v5, v13, s39
  v_add_u32 v61, v61, v5
  v_and_b32 v61, 0xffffff00, v61
L_cproc:
  s_waitcnt vmcnt(0)
  v_xor_b32 v84, v31, v61
  v_xor_b32 v85, v35, v61
  v_cmp_lt_u32 s[80:81], s36, v84
  v_cmp_lt_u32 s[82:83], s36, v85
  v_lshlrev_b32 v84, v62, v84
  v_lshlrev_b32 v85, v62, v85
  s_or_b64 s[56:57], s[80:81], s[82:83]
  s_cbranch_scc1 L_cagain
  v_or_b32_dpp v84, v84, v84 quad_perm:[1,0,3,2] row_mask:0xf bank_mask:0xf
  v_or_b32_dpp v85, v85, v85 quad_perm:[1,0,3,2] row_mask:0xf bank_mask:0xf
  v_lshlrev_b32 v72, 16, v28
  v_or_b32_dpp v84, v84, v84 quad_perm:[2,3,0,1] row_mask:0xf bank_mask:0xf
  v_or_b32_dpp v85, v85, v85 quad_perm:[2,3,0,1] row_mask:0xf bank_mask:0xf
  v_pk_add_f32 v[86:87], v[84:85], v[66:67] op_sel_hi:[1,0] neg_lo:[0,1] neg_hi:[0,1]
  v_exp_f32 v86, v86
  v_exp_f32 v87, v87
  v_and_b32 v73, 0xffff0000, v28
  v_lshlrev_b32 v74, 16, v29
  v_and_b32 v75, 0xffff0000, v29
  v_lshlrev_b32 v76, 16, v30
  v_and_b32 v77, 0xffff0000, v30
  v_lshlrev_b32 v78, 16, v32
  v_and_b32 v79, 0xffff0000, v32
  v_lshlrev_b32 v80, 16, v33
  v_and_b32 v81, 0xffff0000, v33
  v_lshlrev_b32 v82, 16, v34
  v_and_b32 v83, 0xffff0000, v34
  v_pk_mul_f32 v[44:45], v[72:73], v[86:87] op_sel_hi:[1,0]
  v_pk_mul_f32 v[46:47], v[74:75], v[86:87] op_sel_hi:[1,0]
  v_pk_mul_f32 v[48:49], v[76:77], v[86:87] op_sel_hi:[1,0]
  v_pk_fma_f32 v[44:45], v[78:79], v[86:87], v[44:45] op_sel:[0,1,0] op_sel_hi:[1,1,1]
  v_pk_fma_f32 v[48:49], v[82:83], v[86:87], v[48:49] op_sel:[0,1,0] op_sel_hi:[1,1,1]
  v_pk_fma_f32 v[46:47], v[80:81], v[86:87], v[46:47] op_sel:[0,1,0] op_sel_hi:[1,1,1]
  v_add_f32 v50, v86, v87
  v_permlane32_swap_b32 v44, v48
  v_permlane32_swap_b32 v45, v49
  v_permlane32_swap_b32 v46, v50
  v_permlane32_swap_b32 v47, v51
  v_pk_add_f32 v[44:45], v[44:45], v[48:49]
  v_pk_add_f32 v[46:47], v[46:47], v[50:51]
  s_nop 1
  v_permlane16_swap_b32 v44, v46
  v_permlane16_swap_b32 v45, v47
  v_pk_add_f32 v[44:45], v[44:45], v[46:47]
  ds_write_b64 v63, v[44:45]
  s_waitcnt lgkmcnt(0)
  s_barrier
  ds_read2st64_b64 v[88:91], v64 offset0:0 offset1:1
  ds_read2st64_b64 v[92:95], v64 offset0:2 offset1:3
  ds_read2st64_b64 v[96:99], v64 offset0:4 offset1:5
  ds_read2st64_b64 v[100:103], v64 offset0:6 offset1:7
  s_waitcnt lgkmcnt(3)
  v_pk_add_f32 v[88:89], v[88:89], v[90:91]
  s_waitcnt lgkmcnt(2)
  v_pk_add_f32 v[92:93], v[92:93], v[94:95]
  v_pk_add_f32 v[88:89], v[88:89], v[92:93]
  s_waitcnt lgkmcnt(1)
  v_pk_add_f32 v[96:97], v[96:97], v[98:99]
  v_pk_add_f32 v[88:89], v[88:89], v[96:97]
  s_waitcnt lgkmcnt(0)
  v_pk_add_f32 v[100:101], v[100:101], v[102:103]
  v_pk_add_f32 v[88:89], v[88:89], v[100:101]
  s_nop 1
  v_add_f32_dpp v88, v88, v88 row_ror:8 row_mask:0xf bank_mask:0xf
  v_add_f32_dpp v89, v89, v89 row_ror:8 row_mask:0xf bank_mask:0xf
  s_nop 0
  v_add_f32_dpp v88, v88, v88 row_ror:4 row_mask:0xf bank_mask:0xf
  v_add_f32_dpp v89, v89, v89 row_ror:4 row_mask:0xf bank_mask:0xf
  v_readlane_b32 s38, v88, 48
  s_mov_b32 exec_lo, 0x000f000f
  s_mov_b32 exec_hi, 15
  v_rcp_f32 v5, s38
  s_cmp_ge_u32 s38, 0x71800000
  s_cbranch_scc1 L_cover
L_cfin:
  s_cmp_lg_u32 s27, 0
  s_cbranch_scc1 L_cend
  v_fma_f32 v88, v88, v5, v26
  v_fma_f32 v89, v89, v5, v27
  v_cvt_pk_bf16_f32 v5, v88, v89
  global_store_dword v25, v5, s[18:19] sc1
  s_cmp_lg_u32 s2, 0
  s_cbranch_scc1 L_cend
  s_mov_b64 exec, 1
  v_mov_b32 v6, 1048576
  global_store_dword v6, v165, s[22:23] sc1
L_cend:
  s_endpgm
L_cagain:
  s_wqm_b64 exec, s[80:81]
  s_cbranch_execz L_csk0
  global_load_dwordx4 v[28:31], v60, s[22:23] offset:0 sc1
L_csk0:
  s_wqm_b64 exec, s[82:83]
  s_cbranch_execz L_csk1
  global_load_dwordx4 v[32:35], v60, s[22:23] offset:1024 sc1
L_csk1:
  s_mov_b64 exec, -1
  s_sub_u32 s33, s33, 64
  s_cbranch_scc0 L_cproc
  s_endpgm
L_cover:
  s_cmp_lg_u32 s37, 0
  s_cbranch_scc1 L_cfin
  s_mov_b32 s37, 1
  s_mov_b64 exec, -1
  v_max3_f32 v66, v66, v84, v85
  ds_max_f32 v65, v66 offset:64
  s_waitcnt lgkmcnt(0)
  s_barrier
  ds_read_b32 v66, v65 offset:64
  s_waitcnt lgkmcnt(0)
  s_branch L_cproc
L_proj:
  v_mov_b32 v165, 1048576
  global_load_dword v165, v165, s[22:23] sc1
  s_cmp_eq_u32 s27, 3
  s_cbranch_scc1 L_wdone
L_poll_15:
  ds_read_b32 v5, v4 offset:12
  s_sub_u32 s33, s33, 1
  s_cbranch_scc1 L_exit
  s_waitcnt lgkmcnt(0)
  v_readfirstlane_b32 s31, v5
  s_nop 0
  s_cmp_ge_i32 s31, 3
  s_cbranch_scc1 L_done_16
  s_sleep 1
  s_branch L_poll_15
L_done_16:
  s_mov_b32 s48, s27
  s_mul_i32 s49, s27, 1
  s_add_u32 s49, s49, 8
L_wload:
  s_cmp_ge_i32 s30, s49
  s_cbranch_scc1 L_done_18
L_poll_17:
  ds_read_b32 v5, v4 offset:0
  s_sub_u32 s33, s33, 1
  s_cbranch_scc1 L_exit
  s_waitcnt lgkmcnt(0)
  v_readfirstlane_b32 s30, v5
  s_nop 0
  s_cmp_ge_i32 s30, s49
  s_cbranch_scc1 L_done_18
  s_sleep 8
  s_branch L_poll_17
L_done_18:
  s_mul_i32 s38, s48, 3072
  s_add_u32 m0, s38, 122880
  s_cmp_lt_u32 s48, 6
  s_cselect_b64 s[40:41], s[14:15], s[16:17]
  s_cselect_b32 s39, 0, 18432
  s_sub_u32 s38, s38, s39
  v_add_u32 v6, s38, v1
  global_load_lds_dwordx4 v6, s[40:41] offset:0
  global_load_lds_dwordx4 v6, s[40:41] offset:1024
  global_load_lds_dwordx4 v6, s[40:41] offset:2048
  s_add_u32 s48, s48, 3
  s_add_u32 s49, s49, 3
  s_cmp_lt_u32 s48, 12
  s_cbranch_scc1 L_wload
L_wdone:
  v_lshl_add_u32 v6, v11, 3, v12
  v_mul_u32_u24 v6, 192, v6
  s_mul_i32 s38, s27, 48
  s_add_u32 s38, s38, 141312
  v_lshl_add_u32 v7, v13, 3, v6
  v_add_u32 v7, s38, v7
  s_mul_i32 s38, s27, 48
  s_add_u32 s38, s38, 141344
  v_lshrrev_b32 v8, 1, v13
  v_lshl_add_u32 v8, v8, 3, v6
  v_add_u32 v8, s38, v8
  v_mul_u32_u24 v2, 192, v10
  v_lshl_add_u32 v2, v11, 4, v2
  v_add_u32 v2, 122880, v2
  s_waitcnt vmcnt(0)
  v_add_u32 v165, 1, v165
  ds_write_b32 v4, v165 offset:28
  s_mov_b64 exec, 1
  ds_add_u32 v4, v9 offset:24
  s_mov_b64 exec, -1
L_poll_19:
  ds_read_b32 v5, v4 offset:24
  s_sub_u32 s33, s33, 1
  s_cbranch_scc1 L_exit
  s_waitcnt lgkmcnt(0)
  v_readfirstlane_b32 s31, v5
  s_nop 0
  s_cmp_ge_i32 s31, 4
  s_cbranch_scc1 L_done_20
  s_sleep 2
  s_branch L_poll_19
L_done_20:
  ds_read_b64_tr_b16 v[24:25], v7 offset:0
  ds_read_b64_tr_b16 v[26:27], v7 offset:768
  ds_read_b64_tr_b16 v[28:29], v7 offset:6144
  ds_read_b64_tr_b16 v[30:31], v7 offset:6912
  ds_read_b64_tr_b16 v[32:33], v7 offset:12288
  ds_read_b64_tr_b16 v[34:35], v7 offset:13056
  ds_read_b64_tr_b16 v[36:37], v8 offset:0
  ds_read_b64_tr_b16 v[38:39], v8 offset:768
  ds_read_b64_tr_b16 v[40:41], v8 offset:6144
  ds_read_b64_tr_b16 v[42:43], v8 offset:6912
  ds_read_b64_tr_b16 v[44:45], v8 offset:12288
  ds_read_b64_tr_b16 v[46:47], v8 offset:13056
  ds_read_b128 v[84:87], v2 offset:0
  ds_read_b128 v[88:91], v2 offset:64
  ds_read_b128 v[92:95], v2 offset:128
  s_waitcnt lgkmcnt(3)
  v_mov_b32_dpp v36, v36 quad_perm:[2,3,0,1] row_mask:0xf bank_mask:0xa
  v_mov_b32_dpp v37, v37 quad_perm:[2,3,0,1] row_mask:0xf bank_mask:0xa
  v_mov_b32_dpp v38, v38 quad_perm:[2,3,0,1] row_mask:0xf bank_mask:0xa
  v_mov_b32_dpp v39, v39 quad_perm:[2,3,0,1] row_mask:0xf bank_mask:0xa
  v_mov_b32_dpp v40, v40 quad_perm:[2,3,0,1] row_mask:0xf bank_mask:0xa
  v_mov_b32_dpp v41, v41 quad_perm:[2,3,0,1] row_mask:0xf bank_mask:0xa
  v_mov_b32_dpp v42, v42 quad_perm:[2,3,0,1] row_mask:0xf bank_mask:0xa
  v_mov_b32_dpp v43, v43 quad_perm:[2,3,0,1] row_mask:0xf bank_mask:0xa
  v_mov_b32_dpp v44, v44 quad_perm:[2,3,0,1] row_mask:0xf bank_mask:0xa
  v_mov_b32_dpp v45, v45 quad_perm:[2,3,0,1] row_mask:0xf bank_mask:0xa
  v_mov_b32_dpp v46, v46 quad_perm:[2,3,0,1] row_mask:0xf bank_mask:0xa
  v_mov_b32_dpp v47, v47 quad_perm:[2,3,0,1] row_mask:0xf bank_mask:0xa
  ds_read_b128 v[96:99], v2 offset:3072
  ds_read_b128 v[100:103], v2 offset:3136
  ds_read_b128 v[104:107], v2 offset:3200
  s_waitcnt lgkmcnt(3)
  v_mfma_f32_16x16x32_bf16 v[132:135], v[84:87], v[24:27], 0
  v_mfma_f32_16x16x32_bf16 v[136:139], v[84:87], v[36:39], 0
  v_mfma_f32_16x16x32_bf16 v[132:135], v[88:91], v[28:31], v[132:135]
  v_mfma_f32_16x16x32_bf16 v[136:139], v[88:91], v[40:43], v[136:139]
  v_mfma_f32_16x16x32_bf16 v[132:135], v[92:95], v[32:35], v[132:135]
  v_mfma_f32_16x16x32_bf16 v[136:139], v[92:95], v[44:47], v[136:139]
  ds_read_b128 v[84:87], v2 offset:6144
  ds_read_b128 v[88:91], v2 offset:6208
  ds_read_b128 v[92:95], v2 offset:6272
  s_waitcnt lgkmcnt(3)
  v_mfma_f32_16x16x32_bf16 v[140:143], v[96:99], v[24:27], 0
  v_mfma_f32_16x16x32_bf16 v[144:147], v[96:99], v[36:39], 0
  v_mfma_f32_16x16x32_bf16 v[140:143], v[100:103], v[28:31], v[140:143]
  v_mfma_f32_16x16x32_bf16 v[144:147], v[100:103], v[40:43], v[144:147]
  v_mfma_f32_16x16x32_bf16 v[140:143], v[104:107], v[32:35], v[140:143]
  v_mfma_f32_16x16x32_bf16 v[144:147], v[104:107], v[44:47], v[144:147]
  v_cvt_pk_bf16_f32 v108, v132, v133
  v_cvt_pk_bf16_f32 v109, v134, v135
  v_cvt_pk_bf16_f32 v120, v136, v137
  v_cvt_pk_bf16_f32 v121, v138, v139
  ds_read_b128 v[96:99], v2 offset:9216
  ds_read_b128 v[100:103], v2 offset:9280
  ds_read_b128 v[104:107], v2 offset:9344
  s_waitcnt lgkmcnt(3)
  v_mfma_f32_16x16x32_bf16 v[132:135], v[84:87], v[24:27], 0
  v_mfma_f32_16x16x32_bf16 v[136:139], v[84:87], v[36:39], 0
  v_mfma_f32_16x16x32_bf16 v[132:135], v[88:91], v[28:31], v[132:135]
  v_mfma_f32_16x16x32_bf16 v[136:139], v[88:91], v[40:43], v[136:139]
  v_mfma_f32_16x16x32_bf16 v[132:135], v[92:95], v[32:35], v[132:135]
  v_mfma_f32_16x16x32_bf16 v[136:139], v[92:95], v[44:47], v[136:139]
  v_cvt_pk_bf16_f32 v110, v140, v141
  v_cvt_pk_bf16_f32 v111, v142, v143
  v_cvt_pk_bf16_f32 v122, v144, v145
  v_cvt_pk_bf16_f32 v123, v146, v147
  ds_read_b128 v[84:87], v2 offset:12288
  ds_read_b128 v[88:91], v2 offset:12352
  ds_read_b128 v[92:95], v2 offset:12416
  s_waitcnt lgkmcnt(3)
  v_mfma_f32_16x16x32_bf16 v[140:143], v[96:99], v[24:27], 0
  v_mfma_f32_16x16x32_bf16 v[144:147], v[96:99], v[36:39], 0
  v_mfma_f32_16x16x32_bf16 v[140:143], v[100:103], v[28:31], v[140:143]
  v_mfma_f32_16x16x32_bf16 v[144:147], v[100:103], v[40:43], v[144:147]
  v_mfma_f32_16x16x32_bf16 v[140:143], v[104:107], v[32:35], v[140:143]
  v_mfma_f32_16x16x32_bf16 v[144:147], v[104:107], v[44:47], v[144:147]
  v_cvt_pk_bf16_f32 v112, v132, v133
  v_cvt_pk_bf16_f32 v113, v134, v135
  v_cvt_pk_bf16_f32 v124, v136, v137
  v_cvt_pk_bf16_f32 v125, v138, v139
  ds_read_b128 v[96:99], v2 offset:15360
  ds_read_b128 v[100:103], v2 offset:15424
  ds_read_b128 v[104:107], v2 offset:15488
  s_waitcnt lgkmcnt(3)
  v_mfma_f32_16x16x32_bf16 v[132:135], v[84:87], v[24:27], 0
  v_mfma_f32_16x16x32_bf16 v[136:139], v[84:87], v[36:39], 0
  v_mfma_f32_16x16x32_bf16 v[132:135], v[88:91], v[28:31], v[132:135]
  v_mfma_f32_16x16x32_bf16 v[136:139], v[88:91], v[40:43], v[136:139]
  v_mfma_f32_16x16x32_bf16 v[132:135], v[92:95], v[32:35], v[132:135]
  v_mfma_f32_16x16x32_bf16 v[136:139], v[92:95], v[44:47], v[136:139]
  v_cvt_pk_bf16_f32 v114, v140, v141
  v_cvt_pk_bf16_f32 v115, v142, v143
  v_cvt_pk_bf16_f32 v126, v144, v145
  v_cvt_pk_bf16_f32 v127, v146, v147
  s_waitcnt lgkmcnt(0)
  v_mfma_f32_16x16x32_bf16 v[140:143], v[96:99], v[24:27], 0
  v_mfma_f32_16x16x32_bf16 v[144:147], v[96:99], v[36:39], 0
  v_mfma_f32_16x16x32_bf16 v[140:143], v[100:103], v[28:31], v[140:143]
  v_mfma_f32_16x16x32_bf16 v[144:147], v[100:103], v[40:43], v[144:147]
  v_mfma_f32_16x16x32_bf16 v[140:143], v[104:107], v[32:35], v[140:143]
  v_mfma_f32_16x16x32_bf16 v[144:147], v[104:107], v[44:47], v[144:147]
  v_cvt_pk_bf16_f32 v116, v132, v133
  v_cvt_pk_bf16_f32 v117, v134, v135
  v_cvt_pk_bf16_f32 v128, v136, v137
  v_cvt_pk_bf16_f32 v129, v138, v139
  v_mov_b32 v56, 0
  v_mov_b32 v57, 0
  v_mov_b32 v58, 0
  v_mov_b32 v59, 0
  v_mov_b32 v60, 0
  v_mov_b32 v61, 0
  v_mov_b32 v62, 0
  v_mov_b32 v63, 0
  v_cvt_pk_bf16_f32 v118, v140, v141
  v_cvt_pk_bf16_f32 v119, v142, v143
  v_cvt_pk_bf16_f32 v130, v144, v145
  v_cvt_pk_bf16_f32 v131, v146, v147
  v_cmp_le_u32 vcc, 2, v13
  s_nop 1
  v_cndmask_b32 v120, v120, v16, vcc
  v_cndmask_b32 v121, v121, v16, vcc
  v_cndmask_b32 v122, v122, v16, vcc
  v_cndmask_b32 v123, v123, v16, vcc
  v_cndmask_b32 v124, v124, v16, vcc
  v_cndmask_b32 v125, v125, v16, vcc
  v_cndmask_b32 v126, v126, v16, vcc
  v_cndmask_b32 v127, v127, v16, vcc
  v_cndmask_b32 v128, v128, v16, vcc
  v_cndmask_b32 v129, v129, v16, vcc
  v_cndmask_b32 v130, v130, v16, vcc
  v_cndmask_b32 v131, v131, v16, vcc
  v_mfma_f32_16x16x32_bf16 v[48:51], v[108:111], v[16:19], 0
  v_mfma_f32_16x16x32_bf16 v[52:55], v[120:123], v[16:19], 0
  v_mfma_f32_16x16x32_bf16 v[48:51], v[112:115], v[16:19], v[48:51]
  v_mfma_f32_16x16x32_bf16 v[52:55], v[124:127], v[16:19], v[52:55]
  v_mfma_f32_16x16x32_bf16 v[48:51], v[116:119], v[16:19], v[48:51]
  v_mfma_f32_16x16x32_bf16 v[52:55], v[128:131], v[16:19], v[52:55]
  s_branch L_over7
.p2align 12
L_pad7:
  s_branch L_proj
L_over7:
L_nowvo:
  v_mov_b32 v22, 0xff000000
  v_mov_b32 v23, 0
  v_lshlrev_b32 v8, 3, v10
  v_add_u32 v8, 86016, v8
  v_add_u32 v7, 86016, v1
  v_mov_b32 v6, v4
  s_lshl_b32 s38, s27, 14
  s_lshl_b32 s39, s2, 6
  s_add_u32 s38, s38, s39
  v_lshlrev_b32 v2, 16, v10
  v_lshl_add_u32 v2, v11, 4, v2
  v_add_u32 v2, s38, v2
  v_mul_f32 v48, s44, v48
  v_mul_f32 v49, s44, v49
  v_mul_f32 v50, s44, v50
  v_mul_f32 v51, s44, v51
  v_mul_f32 v52, s44, v52
  v_mul_f32 v53, s44, v53
  s_mov_b32 s38, 0x9E3779B1
  s_mov_b32 s39, 0x2545F500
  v_mul_lo_u32 v3, v165, s38
  v_mul_lo_u32 v5, v11, s39
  v_add_u32 v3, v3, v5
  v_and_b32 v3, 0xffffff00, v3
  v_lshlrev_b32 v15, 3, v11
  s_cmp_ge_i32 s30, 44
  s_cbranch_scc1 L_done_22
L_poll_21:
  ds_read_b32 v5, v4 offset:0
  s_sub_u32 s33, s33, 1
  s_cbranch_scc1 L_exit
  s_waitcnt lgkmcnt(0)
  v_readfirstlane_b32 s30, v5
  s_nop 0
  s_cmp_ge_i32 s30, 44
  s_cbranch_scc1 L_done_22
  s_sleep 8
  s_branch L_poll_21
L_done_22:
  global_load_dwordx4 v[156:159], v2, s[22:23]
  s_mov_b32 s34, 0
L_poll_23:
  ds_read_b32 v5, v4 offset:32
  s_sub_u32 s33, s33, 1
  s_cbranch_scc1 L_exit
  s_waitcnt lgkmcnt(0)
  v_readfirstlane_b32 s31, v5
  s_nop 0
  s_cmp_ge_i32 s31, 1
  s_cbranch_scc1 L_done_24
  s_sleep 2
  s_branch L_poll_23
L_done_24:
  s_setprio 1
  v_add_u32 v9, 4294890496, v7
  v_add_u32 v14, 4294890496, v8
L_ptail:
  ds_read_b32 v5, v4 offset:32
  ds_read_b64 v[76:77], v8 offset:3072
  ds_read_b128 v[64:67], v7 offset:0
  ds_read_b128 v[68:71], v7 offset:1024
  ds_read_b128 v[72:75], v7 offset:2048
L_pchk0:
  s_waitcnt lgkmcnt(3)
  v_readfirstlane_b32 s31, v5
  v_max_f32 v6, v22, v76
  v_sub_f32 v82, v22, v6
  s_cmp_lg_u32 s31, 0
  s_cbranch_scc1 L_pok0
  ds_read_b32 v5, v4 offset:32
  ds_read_b64 v[76:77], v8 offset:3072
  ds_read_b128 v[64:67], v7 offset:0
  ds_read_b128 v[68:71], v7 offset:1024
  ds_read_b128 v[72:75], v7 offset:2048
  s_sub_u32 s33, s33, 1
  s_cbranch_scc1 L_exit
  s_branch L_pchk0
L_pok0:
  ds_read_b32 v98, v4 offset:36
  ds_read_b64 v[96:97], v8 offset:18432
  ds_read_b128 v[84:87], v7 offset:15360
  ds_read_b128 v[88:91], v7 offset:16384
  ds_read_b128 v[92:95], v7 offset:17408
  s_waitcnt lgkmcnt(7)
  v_mfma_f32_16x16x32_bf16 v[132:135], v[108:111], v[64:67], 0
  v_sub_f32 v79, v76, v6
  v_exp_f32 v78, v82
  v_mfma_f32_16x16x32_bf16 v[136:139], v[120:123], v[64:67], 0
  v_exp_f32 v79, v79
  s_waitcnt lgkmcnt(6)
  v_mfma_f32_16x16x32_bf16 v[132:135], v[112:115], v[68:71], v[132:135]
  v_mov_b32 v22, v6
  v_fmac_f32 v23, v77, v79
  v_mfma_f32_16x16x32_bf16 v[136:139], v[124:127], v[68:71], v[136:139]
  s_waitcnt lgkmcnt(5)
  v_mfma_f32_16x16x32_bf16 v[132:135], v[116:119], v[72:75], v[132:135]
  v_mfma_f32_16x16x32_bf16 v[136:139], v[128:131], v[72:75], v[136:139]
  s_nop 3
L_pchk1:
  s_waitcnt lgkmcnt(3)
  v_readfirstlane_b32 s31, v98
  v_max_f32 v6, v22, v96
  v_sub_f32 v82, v22, v6
  s_cmp_lg_u32 s31, 0
  s_cbranch_scc1 L_pok1
  ds_read_b32 v98, v4 offset:36
  ds_read_b64 v[96:97], v8 offset:18432
  ds_read_b128 v[84:87], v7 offset:15360
  ds_read_b128 v[88:91], v7 offset:16384
  ds_read_b128 v[92:95], v7 offset:17408
  s_sub_u32 s33, s33, 1
  s_cbranch_scc1 L_exit
  s_branch L_pchk1
L_pok1:
  ds_read_b32 v5, v4 offset:40
  ds_read_b64 v[76:77], v8 offset:33792
  ds_read_b128 v[64:67], v7 offset:30720
  ds_read_b128 v[68:71], v7 offset:31744
  ds_read_b128 v[72:75], v7 offset:32768
  v_pk_fma_f32 v[56:57], v[132:133], v[78:79], v[56:57] op_sel:[0,1,0] op_sel_hi:[1,1,1]
  v_pk_fma_f32 v[58:59], v[134:135], v[78:79], v[58:59] op_sel:[0,1,0] op_sel_hi:[1,1,1]
  v_pk_fma_f32 v[60:61], v[136:137], v[78:79], v[60:61] op_sel:[0,1,0] op_sel_hi:[1,1,1]
  v_pk_fma_f32 v[62:63], v[138:139], v[78:79], v[62:63] op_sel:[0,1,0] op_sel_hi:[1,1,1]
  s_waitcnt lgkmcnt(7)
  v_mfma_f32_16x16x32_bf16 v[132:135], v[108:111], v[84:87], 0
  v_sub_f32 v79, v96, v6
  v_exp_f32 v78, v82
  v_mfma_f32_16x16x32_bf16 v[136:139], v[120:123], v[84:87], 0
  v_exp_f32 v79, v79
  s_waitcnt lgkmcnt(6)
  v_mfma_f32_16x16x32_bf16 v[132:135], v[112:115], v[88:91], v[132:135]
  v_mov_b32 v22, v6
  v_mul_f32 v23, v78, v23
  v_mfma_f32_16x16x32_bf16 v[136:139], v[124:127], v[88:91], v[136:139]
  v_fmac_f32 v23, v97, v79
  s_waitcnt lgkmcnt(5)
  v_mfma_f32_16x16x32_bf16 v[132:135], v[116:119], v[92:95], v[132:135]
  v_mul_f32 v56, v78, v56
  v_mul_f32 v57, v78, v57
  v_mfma_f32_16x16x32_bf16 v[136:139], v[128:131], v[92:95], v[136:139]
  v_mul_f32 v58, v78, v58
  v_mul_f32 v59, v78, v59
  v_mul_f32 v60, v78, v60
  v_mul_f32 v61, v78, v61
  v_mul_f32 v62, v78, v62
  v_mul_f32 v63, v78, v63
L_pchk2:
  s_waitcnt lgkmcnt(3)
  v_readfirstlane_b32 s31, v5
  v_max_f32 v6, v22, v76
  v_sub_f32 v82, v22, v6
  s_cmp_lg_u32 s31, 0
  s_cbranch_scc1 L_pok2
  ds_read_b32 v5, v4 offset:40
  ds_read_b64 v[76:77], v8 offset:33792
  ds_read_b128 v[64:67], v7 offset:30720
  ds_read_b128 v[68:71], v7 offset:31744
  ds_read_b128 v[72:75], v7 offset:32768
  s_sub_u32 s33, s33, 1
  s_cbranch_scc1 L_exit
  s_branch L_pchk2
L_pok2:
  ds_read_b32 v98, v4 offset:44
  ds_read_b64 v[96:97], v14 offset:3072
  ds_read_b128 v[84:87], v9 offset:0
  ds_read_b128 v[88:91], v9 offset:1024
  ds_read_b128 v[92:95], v9 offset:2048
  v_pk_fma_f32 v[56:57], v[132:133], v[78:79], v[56:57] op_sel:[0,1,0] op_sel_hi:[1,1,1]
  v_pk_fma_f32 v[58:59], v[134:135], v[78:79], v[58:59] op_sel:[0,1,0] op_sel_hi:[1,1,1]
  v_pk_fma_f32 v[60:61], v[136:137], v[78:79], v[60:61] op_sel:[0,1,0] op_sel_hi:[1,1,1]
  v_pk_fma_f32 v[62:63], v[138:139], v[78:79], v[62:63] op_sel:[0,1,0] op_sel_hi:[1,1,1]
  s_waitcnt lgkmcnt(7)
  v_mfma_f32_16x16x32_bf16 v[132:135], v[108:111], v[64:67], 0
  v_sub_f32 v79, v76, v6
  v_exp_f32 v78, v82
  v_mfma_f32_16x16x32_bf16 v[136:139], v[120:123], v[64:67], 0
  v_exp_f32 v79, v79
  s_waitcnt lgkmcnt(6)
  v_mfma_f32_16x16x32_bf16 v[132:135], v[112:115], v[68:71], v[132:135]
  v_mov_b32 v22, v6
  v_mul_f32 v23, v78, v23
  v_mfma_f32_16x16x32_bf16 v[136:139], v[124:127], v[68:71], v[136:139]
  v_fmac_f32 v23, v77, v79
  s_waitcnt lgkmcnt(5)
  v_mfma_f32_16x16x32_bf16 v[132:135], v[116:119], v[72:75], v[132:135]
  v_mul_f32 v56, v78, v56
  v_mul_f32 v57, v78, v57
  v_mfma_f32_16x16x32_bf16 v[136:139], v[128:131], v[72:75], v[136:139]
  v_mul_f32 v58, v78, v58
  v_mul_f32 v59, v78, v59
  v_mul_f32 v60, v78, v60
  v_mul_f32 v61, v78, v61
  v_mul_f32 v62, v78, v62
  v_mul_f32 v63, v78, v63
L_pchk3:
  s_waitcnt lgkmcnt(3)
  v_readfirstlane_b32 s31, v98
  v_max_f32 v6, v22, v96
  v_sub_f32 v82, v22, v6
  s_cmp_lg_u32 s31, 0
  s_cbranch_scc1 L_pok3
  ds_read_b32 v98, v4 offset:44
  ds_read_b64 v[96:97], v14 offset:3072
  ds_read_b128 v[84:87], v9 offset:0
  ds_read_b128 v[88:91], v9 offset:1024
  ds_read_b128 v[92:95], v9 offset:2048
  s_sub_u32 s33, s33, 1
  s_cbranch_scc1 L_exit
  s_branch L_pchk3
L_pok3:
  v_pk_fma_f32 v[56:57], v[132:133], v[78:79], v[56:57] op_sel:[0,1,0] op_sel_hi:[1,1,1]
  v_pk_fma_f32 v[58:59], v[134:135], v[78:79], v[58:59] op_sel:[0,1,0] op_sel_hi:[1,1,1]
  v_pk_fma_f32 v[60:61], v[136:137], v[78:79], v[60:61] op_sel:[0,1,0] op_sel_hi:[1,1,1]
  v_pk_fma_f32 v[62:63], v[138:139], v[78:79], v[62:63] op_sel:[0,1,0] op_sel_hi:[1,1,1]
  s_waitcnt lgkmcnt(2)
  v_mfma_f32_16x16x32_bf16 v[132:135], v[108:111], v[84:87], 0
  v_sub_f32 v79, v96, v6
  v_exp_f32 v78, v82
  v_mfma_f32_16x16x32_bf16 v[136:139], v[120:123], v[84:87], 0
  v_exp_f32 v79, v79
  s_waitcnt lgkmcnt(1)
  v_mfma_f32_16x16x32_bf16 v[132:135], v[112:115], v[88:91], v[132:135]
  v_mov_b32 v22, v6
  v_mul_f32 v23, v78, v23
  v_mfma_f32_16x16x32_bf16 v[136:139], v[124:127], v[88:91], v[136:139]
  v_fmac_f32 v23, v97, v79
  s_waitcnt lgkmcnt(0)
  v_mfma_f32_16x16x32_bf16 v[132:135], v[116:119], v[92:95], v[132:135]
  v_mul_f32 v56, v78, v56
  v_mul_f32 v57, v78, v57
  v_mfma_f32_16x16x32_bf16 v[136:139], v[128:131], v[92:95], v[136:139]
  v_mul_f32 v58, v78, v58
  v_mul_f32 v59, v78, v59
  v_mul_f32 v60, v78, v60
  v_mul_f32 v61, v78, v61
  v_mul_f32 v62, v78, v62
  v_mul_f32 v63, v78, v63
L_pfin:
  v_log_f32 v147, v23
  v_rcp_f32 v80, v23
  v_add_f32 v83, v147, v22
  v_bfe_u32 v147, v83, v15, 8
  v_pk_fma_f32 v[56:57], v[132:133], v[78:79], v[56:57] op_sel:[0,1,0] op_sel_hi:[1,1,1]
  v_pk_fma_f32 v[58:59], v[134:135], v[78:79], v[58:59] op_sel:[0,1,0] op_sel_hi:[1,1,1]
  v_pk_fma_f32 v[60:61], v[136:137], v[78:79], v[60:61] op_sel:[0,1,0] op_sel_hi:[1,1,1]
  v_pk_fma_f32 v[62:63], v[138:139], v[78:79], v[62:63] op_sel:[0,1,0] op_sel_hi:[1,1,1]
  v_pk_fma_f32 v[148:149], v[62:63], v[48:49], v[56:57]
  v_pk_fma_f32 v[150:151], v[62:63], v[50:51], v[58:59]
  v_pk_fma_f32 v[152:153], v[62:63], v[52:53], v[60:61]
  v_pk_mul_f32 v[148:149], v[148:149], v[80:81] op_sel_hi:[1,0]
  v_pk_mul_f32 v[150:151], v[150:151], v[80:81] op_sel_hi:[1,0]
  v_pk_mul_f32 v[152:153], v[152:153], v[80:81] op_sel_hi:[1,0]
  v_or_b32 v147, v147, v3
  v_cvt_pk_bf16_f32 v144, v148, v149
  v_cvt_pk_bf16_f32 v145, v150, v151
  v_cvt_pk_bf16_f32 v146, v152, v153
  global_store_dwordx4 v2, v[144:147], s[22:23] sc1
  s_cmp_ge_u32 s2, 64
  s_cbranch_scc1 L_pend
  v_lshl_add_u32 v5, v10, 2, v4
  ds_write_b32 v5, v83 offset:64
  s_add_u32 s27, s27, 4
  s_branch L_consume
L_pend:
L_exit:
  s_endpgm
L_code_end:
.section .rodata,"a"
.p2align 6
.amdhsa_kernel standalone__detection_seg_dino__vision_kernel
  .amdhsa_next_free_vgpr 168
  .amdhsa_next_free_sgpr 96
  .amdhsa_accum_offset 168
  .amdhsa_group_segment_fixed_size 0
  .amdhsa_kernarg_size 80
  .amdhsa_user_sgpr_count 2
  .amdhsa_user_sgpr_kernarg_segment_ptr 1
  .amdhsa_system_sgpr_workgroup_id_x 1
.end_amdhsa_kernel
```
